```python
import torch

def _softmax(x, axis=-1):
    return torch.softmax(x, dim=axis)
def _gelu(x):
    return torch.nn.functional.gelu(x, approximate="tanh")
def _silu(x):
    return torch.nn.functional.silu(x)
def _sigmoid(x):
    return torch.sigmoid(x)
def _layernorm(x, axis=-1, eps=1e-5):
    m = x.mean(dim=axis, keepdim=True)
    v = x.var(dim=axis, keepdim=True, unbiased=False)
    return (x - m) / torch.sqrt(v + eps)
def _scatter_add(tgt, idx, src, axis=0):
    return tgt.clone().index_add_(axis, idx, src)
def _segment_sum(src, seg, n):
    out = torch.zeros((n,) + src.shape[1:], dtype=src.dtype)
    return out.index_add_(0, seg, src)
def _pad(x, pw):
    flat = tuple(v for pair in reversed(pw) for v in pair)
    return torch.nn.functional.pad(x, flat)

kernel_name = 'concat_heads__sliding_block_cached__sliding_block_cached__decode'

def setup_inputs():

    _w = (lambda a: (lambda t: t.to(torch.bfloat16) if t.is_floating_point() else t)(torch.as_tensor(a)))
    def _A_setup():
        B, Sq, D = 8, 1, 1024
        Hq, Hkv, Sk, Dh = 32, 4, 4096, 128
        assert Hq % Hkv == 0, (Hq, Hkv)
        return {
            "x": _w((lambda *s: torch.randn(*s, dtype=torch.bfloat16) * 0.8)(B, Sq, D)),
            "k_cache": _w((lambda *s: torch.randn(*s, dtype=torch.bfloat16) * 0.8)(B, Hkv, Sk, Dh)),
            "v_cache": _w((lambda *s: torch.randn(*s, dtype=torch.bfloat16) * 0.05)(B, Hkv, Sk, Dh)),
            "wq": _w((lambda *s: torch.randn(*s, dtype=torch.bfloat16) * 0.8)(D, Hq * Dh) * (D ** -0.5)),
            "wo": _w((lambda *s: torch.randn(*s, dtype=torch.bfloat16) * 0.05)(Hq * Dh, D) * ((Hq * Dh) ** -0.5)),
        }
    _A_in = _A_setup()

    def _B_setup():
        B, Sq, D = 8, 1, 1024
        Hq, Hkv, Sk, Dh = 32, 4, 4096, 128
        assert Hq % Hkv == 0, (Hq, Hkv)
        return {
            "x": _w((lambda *s: torch.randn(*s, dtype=torch.bfloat16) * 0.8)(B, Sq, D)),
            "k_cache": _w((lambda *s: torch.randn(*s, dtype=torch.bfloat16) * 0.8)(B, Hkv, Sk, Dh)),
            "v_cache": _w((lambda *s: torch.randn(*s, dtype=torch.bfloat16) * 0.05)(B, Hkv, Sk, Dh)),
            "wq": _w((lambda *s: torch.randn(*s, dtype=torch.bfloat16) * 0.8)(D, Hq * Dh) * (D ** -0.5)),
            "wo": _w((lambda *s: torch.randn(*s, dtype=torch.bfloat16) * 0.05)(Hq * Dh, D) * ((Hq * Dh) ** -0.5)),
        }
    _B_in = _B_setup()

    return {
        "A_x": _A_in["x"],
        "A_k_cache": _A_in["k_cache"],
        "A_v_cache": _A_in["v_cache"],
        "A_wq": _A_in["wq"],
        "A_wo": _A_in["wo"],
        "B_x": _B_in["x"],
        "B_k_cache": _B_in["k_cache"],
        "B_v_cache": _B_in["v_cache"],
        "B_wq": _B_in["wq"],
        "B_wo": _B_in["wo"],
    }

def reference(A_x, A_k_cache, A_v_cache, A_wq, A_wo, B_x, B_k_cache, B_v_cache, B_wq, B_wo):
    def _A_ref(x, k_cache, v_cache, wq, wo):
        B, Sq, D = x.shape
        Hq, Dh = 32, 128
        Hkv, Sk = k_cache.shape[1], k_cache.shape[2]
        W = min(4096, max(256, Sk // 4))
        rep = Hq // Hkv
        q = (lambda x, *d: x.permute(*d))((x @ wq).reshape(B, Sq, Hq, Dh), 0, 2, 1, 3)
        k = (lambda x, n, axis: torch.repeat_interleave(x, n, dim=axis))(k_cache[:, :, Sk - W:, :], rep, axis=1)
        v = (lambda x, n, axis: torch.repeat_interleave(x, n, dim=axis))(v_cache[:, :, Sk - W:, :], rep, axis=1)
        scores = torch.einsum("bhqd,bhkd->bhqk", q, k) * (Dh ** -0.5)
        p = _softmax(scores, axis=-1)
        o = torch.einsum("bhqk,bhkd->bhqd", p, v)
        return (lambda x, *d: x.permute(*d))(o, 0, 2, 1, 3).reshape(B, Sq, Hq * Dh) @ wo

    def _B_ref(x, k_cache, v_cache, wq, wo):
        B, Sq, D = x.shape
        Hq, Dh = 32, 128
        Hkv, Sk = k_cache.shape[1], k_cache.shape[2]
        W = min(4096, max(256, Sk // 4))
        rep = Hq // Hkv
        q = (lambda x, *d: x.permute(*d))((x @ wq).reshape(B, Sq, Hq, Dh), 0, 2, 1, 3)
        k = (lambda x, n, axis: torch.repeat_interleave(x, n, dim=axis))(k_cache[:, :, Sk - W:, :], rep, axis=1)
        v = (lambda x, n, axis: torch.repeat_interleave(x, n, dim=axis))(v_cache[:, :, Sk - W:, :], rep, axis=1)
        scores = torch.einsum("bhqd,bhkd->bhqk", q, k) * (Dh ** -0.5)
        p = _softmax(scores, axis=-1)
        o = torch.einsum("bhqk,bhkd->bhqd", p, v)
        return (lambda x, *d: x.permute(*d))(o, 0, 2, 1, 3).reshape(B, Sq, Hq * Dh) @ wo

    a = _A_ref(A_x, A_k_cache, A_v_cache, A_wq, A_wo)
    b = _B_ref(B_x, B_k_cache, B_v_cache, B_wq, B_wo)
    return torch.concatenate([a, b], axis=-1)
```

```asm
; @launch grid=(256,1,1) block=(1024,1,1) lds=33792
.amdgcn_target "amdgcn-amd-amdhsa--gfx950"
.text
.globl concat_heads__sliding_block_cached__sliding_block_cached__decode_kernel
.p2align 8
.type concat_heads__sliding_block_cached__sliding_block_cached__decode_kernel,@function
concat_heads__sliding_block_cached__sliding_block_cached__decode_kernel:
s_cmp_ge_u32 s2, 256
s_cbranch_scc1 L_end
s_and_b32 s5, s2, 1
s_mul_i32 s9, s5, 40
s_add_u32 s10, s0, s9
s_addc_u32 s11, s1, 0
s_load_dwordx8 s[12:19], s[10:11], 0
s_load_dwordx2 s[20:21], s[10:11], 32
s_load_dwordx2 s[22:23], s[0:1], 80
s_load_dwordx2 s[24:25], s[0:1], 96
v_lshrrev_b32 v2, 6, v0
v_and_b32 v1, 63, v0
v_readfirstlane_b32 s8, v2
s_and_b32 s3, s2, 7
s_lshr_b32 s4, s2, 3
s_lshr_b32 s6, s3, 1
s_mov_b32 s44, 0x05040100
s_mov_b32 s45, 0x07060302
s_mov_b32 s26, 0x00ff00ff
s_mov_b32 s27, 0x00ff00ff
s_and_b32 s7, s8, 3
s_lshr_b32 s8, s8, 2
s_cmp_eq_u32 s8, 1
s_cbranch_scc1 L_K
s_cmp_eq_u32 s8, 2
s_cbranch_scc1 L_V
s_cmp_eq_u32 s8, 3
s_cbranch_scc1 L_WO
s_setprio 3
v_lshrrev_b32 v2, 4, v1
v_and_b32 v3, 15, v1
v_lshlrev_b32 v118, 16, v2
v_lshl_add_u32 v118, v3, 4, v118
v_and_b32 v3, 7, v1
v_lshlrev_b32 v120, 11, v3
v_lshl_add_u32 v120, v2, 4, v120
s_lshr_b32 s50, s4, 2
s_and_b32 s51, s4, 3
s_mov_b32 s47, s50
s_add_u32 s53, s7, s47
s_and_b32 s53, s53, 3
s_bfe_u32 s48, s47, 0x10002
s_lshl_b32 s47, s51, 8
s_lshl_b32 s53, s53, 6
s_add_u32 s47, s47, s53
s_lshl_b32 s53, s48, 5
s_add_u32 s47, s47, s53
s_lshl_b32 s46, s47, 13
s_lshl_b32 s52, s47, 1
s_xor_b32 s9, s52, 64
s_lshl_b32 s58, s48, 19
s_sub_u32 s58, 204800, s58
s_lshl_b32 s47, s6, 11
s_add_u32 s46, s46, s47
s_lshl_b32 s47, s50, 8
s_add_u32 s46, s46, s47
s_mov_b32 s30, 8388608
s_mov_b32 s31, 0x20000
s_waitcnt lgkmcnt(0)
s_mov_b32 s28, s18
s_mov_b32 s29, s19
buffer_load_dwordx4 v[4:7], v118, s[28:31], s46 offen nt
s_add_u32 s46, s46, 8192
buffer_load_dwordx4 v[8:11], v118, s[28:31], s46 offen nt
s_add_u32 s46, s46, 8192
buffer_load_dwordx4 v[12:15], v118, s[28:31], s46 offen nt
s_add_u32 s46, s46, 8192
buffer_load_dwordx4 v[16:19], v118, s[28:31], s46 offen nt
s_add_u32 s46, s46, 8192
buffer_load_dwordx4 v[20:23], v118, s[28:31], s46 offen nt
s_add_u32 s46, s46, 8192
buffer_load_dwordx4 v[24:27], v118, s[28:31], s46 offen nt
v_mov_b32 v68, 0
v_mov_b32 v69, 0
v_mov_b32 v70, 0
v_mov_b32 v71, 0
v_mov_b32 v72, 0
v_mov_b32 v73, 0
v_mov_b32 v74, 0
v_mov_b32 v75, 0
v_mov_b32 v76, 0
v_mov_b32 v77, 0
v_mov_b32 v78, 0
v_mov_b32 v79, 0
v_mov_b32 v80, 0
v_mov_b32 v81, 0
v_mov_b32 v82, 0
v_mov_b32 v83, 0
s_mov_b32 s36, s12
s_mov_b32 s37, s13
s_mov_b32 s38, 16384
s_mov_b32 s39, 0x20000
s_mov_b64 exec, s[26:27]
s_waitcnt vmcnt(5)
buffer_load_dwordx4 v[68:71], v120, s[36:39], s52 offen
s_waitcnt vmcnt(5)
buffer_load_dwordx4 v[76:79], v120, s[36:39], s9 offen
s_mov_b64 exec, -1
s_add_u32 s46, s46, 8192
s_waitcnt vmcnt(5)
buffer_load_dwordx4 v[28:31], v118, s[28:31], s46 offen nt
s_add_u32 s46, s46, 8192
s_waitcnt vmcnt(5)
buffer_load_dwordx4 v[32:35], v118, s[28:31], s46 offen nt
s_add_u32 s46, s46, s58
s_waitcnt vmcnt(5)
buffer_load_dwordx4 v[36:39], v118, s[28:31], s46 offen nt
s_add_u32 s46, s46, 8192
s_waitcnt vmcnt(5)
buffer_load_dwordx4 v[40:43], v118, s[28:31], s46 offen nt
s_add_u32 s46, s46, 8192
s_waitcnt vmcnt(5)
buffer_load_dwordx4 v[44:47], v118, s[28:31], s46 offen nt
s_add_u32 s46, s46, 8192
s_waitcnt vmcnt(5)
buffer_load_dwordx4 v[48:51], v118, s[28:31], s46 offen nt
s_add_u32 s46, s46, 8192
s_waitcnt vmcnt(5)
buffer_load_dwordx4 v[52:55], v118, s[28:31], s46 offen nt
s_add_u32 s46, s46, 8192
s_waitcnt vmcnt(5)
buffer_load_dwordx4 v[56:59], v118, s[28:31], s46 offen nt
s_add_u32 s46, s46, 8192
s_waitcnt vmcnt(5)
buffer_load_dwordx4 v[60:63], v118, s[28:31], s46 offen nt
s_add_u32 s46, s46, 8192
s_waitcnt vmcnt(5)
buffer_load_dwordx4 v[64:67], v118, s[28:31], s46 offen nt
s_waitcnt vmcnt(5)
s_barrier
s_mov_b32 s32, s24
s_mov_b32 s33, s25
s_mov_b32 s34, 16777216
s_mov_b32 s35, 0x20000
v_mov_b32 v116, 0
v_mov_b32 v117, 1
v_lshrrev_b32 v2, 4, v1
v_mul_u32_u24 v2, 576, v2
v_bfe_u32 v121, v1, 3, 1
v_lshl_add_u32 v2, v121, 8, v2
v_and_b32 v121, 7, v1
v_lshl_add_u32 v2, v121, 4, v2
s_lshr_b32 s47, s7, 1
s_mul_i32 s47, s47, 8960
s_lshl_b32 s54, s7, 7
s_add_u32 s47, s47, s54
v_add_u32 v120, s47, v2
v_and_b32 v121, 3, v1
v_mul_u32_u24 v121, 2320, v121
v_bfe_u32 v2, v1, 3, 2
v_mul_u32_u24 v2, 576, v2
v_add_u32 v121, v121, v2
v_bfe_u32 v2, v1, 2, 1
v_lshl_add_u32 v121, v2, 8, v121
v_lshrrev_b32 v2, 5, v1
v_lshl_add_u32 v121, v2, 4, v121
s_lshl_b32 s47, s7, 5
v_add_u32 v121, s47, v121
v_mov_b32_dpp v72, v68 row_ror:8 row_mask:0xf bank_mask:0xc
v_mov_b32_dpp v73, v69 row_ror:8 row_mask:0xf bank_mask:0xc
v_mov_b32_dpp v74, v70 row_ror:8 row_mask:0xf bank_mask:0xc
v_mov_b32_dpp v75, v71 row_ror:8 row_mask:0xf bank_mask:0xc
v_mov_b32_dpp v80, v76 row_ror:8 row_mask:0xf bank_mask:0xc
v_mov_b32_dpp v81, v77 row_ror:8 row_mask:0xf bank_mask:0xc
v_mov_b32_dpp v82, v78 row_ror:8 row_mask:0xf bank_mask:0xc
v_mov_b32_dpp v83, v79 row_ror:8 row_mask:0xf bank_mask:0xc
v_lshrrev_b32 v2, 5, v1
v_and_b32 v118, 31, v1
v_lshlrev_b32 v118, 3, v118
v_lshl_add_u32 v122, v2, 10, v118
v_lshl_add_u32 v118, v2, 13, v118
s_lshl_b32 s52, s3, 16
s_add_u32 s52, s52, 524288
s_lshl_b32 s46, s50, 2
s_add_u32 s46, s46, s7
s_lshl_b32 s46, s46, 3
s_add_u32 s46, s46, s51
s_lshl_b32 s46, s46, 8
s_add_u32 s46, s46, s52
v_mul_u32_u24 v2, 272, v2
v_bfe_u32 v123, v1, 3, 2
v_lshl_add_u32 v2, v123, 6, v2
v_lshl_add_u32 v2, v3, 1, v2
s_mul_i32 s47, s7, 544
v_add_u32 v2, s47, v2
v_perm_b32 v100, v8, v4, s44
v_perm_b32 v101, v16, v12, s44
v_perm_b32 v102, v24, v20, s44
v_perm_b32 v103, v32, v28, s44
v_perm_b32 v104, v8, v4, s45
v_perm_b32 v105, v16, v12, s45
v_perm_b32 v106, v24, v20, s45
v_perm_b32 v107, v32, v28, s45
v_mfma_f32_16x16x32_bf16 v[84:87], v[100:103], v[68:71], 0
v_perm_b32 v100, v9, v5, s44
v_perm_b32 v101, v17, v13, s44
v_perm_b32 v102, v25, v21, s44
v_perm_b32 v103, v33, v29, s44
v_mfma_f32_16x16x32_bf16 v[88:91], v[104:107], v[68:71], 0
v_perm_b32 v104, v9, v5, s45
v_perm_b32 v105, v17, v13, s45
v_perm_b32 v106, v25, v21, s45
v_perm_b32 v107, v33, v29, s45
v_mfma_f32_16x16x32_bf16 v[92:95], v[100:103], v[68:71], 0
v_perm_b32 v100, v10, v6, s44
v_perm_b32 v101, v18, v14, s44
v_perm_b32 v102, v26, v22, s44
v_perm_b32 v103, v34, v30, s44
v_mfma_f32_16x16x32_bf16 v[96:99], v[104:107], v[68:71], 0
v_perm_b32 v104, v10, v6, s45
v_perm_b32 v105, v18, v14, s45
v_perm_b32 v106, v26, v22, s45
v_perm_b32 v107, v34, v30, s45
v_mfma_f32_16x16x32_bf16 v[84:87], v[100:103], v[72:75], v[84:87]
v_perm_b32 v100, v11, v7, s44
v_perm_b32 v101, v19, v15, s44
v_perm_b32 v102, v27, v23, s44
v_perm_b32 v103, v35, v31, s44
v_mfma_f32_16x16x32_bf16 v[88:91], v[104:107], v[72:75], v[88:91]
v_perm_b32 v104, v11, v7, s45
v_perm_b32 v105, v19, v15, s45
v_perm_b32 v106, v27, v23, s45
v_perm_b32 v107, v35, v31, s45
v_mfma_f32_16x16x32_bf16 v[92:95], v[100:103], v[72:75], v[92:95]
s_nop 0
v_mfma_f32_16x16x32_bf16 v[96:99], v[104:107], v[72:75], v[96:99]
s_waitcnt vmcnt(6)
v_perm_b32 v4, v40, v36, s44
v_perm_b32 v8, v40, v36, s45
v_perm_b32 v12, v41, v37, s44
v_perm_b32 v16, v41, v37, s45
v_perm_b32 v20, v42, v38, s44
v_perm_b32 v24, v42, v38, s45
v_perm_b32 v28, v43, v39, s44
v_perm_b32 v32, v43, v39, s45
s_waitcnt vmcnt(4)
v_perm_b32 v5, v48, v44, s44
v_perm_b32 v9, v48, v44, s45
v_perm_b32 v13, v49, v45, s44
v_perm_b32 v17, v49, v45, s45
v_perm_b32 v21, v50, v46, s44
v_perm_b32 v25, v50, v46, s45
v_perm_b32 v29, v51, v47, s44
v_perm_b32 v33, v51, v47, s45
s_waitcnt vmcnt(2)
v_perm_b32 v6, v56, v52, s44
v_perm_b32 v10, v56, v52, s45
v_perm_b32 v14, v57, v53, s44
v_perm_b32 v18, v57, v53, s45
v_perm_b32 v22, v58, v54, s44
v_perm_b32 v26, v58, v54, s45
v_perm_b32 v30, v59, v55, s44
v_perm_b32 v34, v59, v55, s45
s_waitcnt vmcnt(0)
v_perm_b32 v7, v64, v60, s44
v_perm_b32 v11, v64, v60, s45
v_perm_b32 v15, v65, v61, s44
v_mfma_f32_16x16x32_bf16 v[84:87], v[4:7], v[76:79], v[84:87]
v_perm_b32 v19, v65, v61, s45
v_mfma_f32_16x16x32_bf16 v[88:91], v[8:11], v[76:79], v[88:91]
v_perm_b32 v23, v66, v62, s44
v_mfma_f32_16x16x32_bf16 v[92:95], v[12:15], v[76:79], v[92:95]
v_perm_b32 v27, v66, v62, s45
v_mfma_f32_16x16x32_bf16 v[96:99], v[16:19], v[76:79], v[96:99]
v_perm_b32 v31, v67, v63, s44
v_mfma_f32_16x16x32_bf16 v[84:87], v[20:23], v[80:83], v[84:87]
v_perm_b32 v35, v67, v63, s45
v_mfma_f32_16x16x32_bf16 v[88:91], v[24:27], v[80:83], v[88:91]
v_mfma_f32_16x16x32_bf16 v[92:95], v[28:31], v[80:83], v[92:95]
v_mfma_f32_16x16x32_bf16 v[96:99], v[32:35], v[80:83], v[96:99]
s_nop 3
ds_write_b128 v120, v[84:87] offset:15360
s_nop 0
ds_write_b128 v120, v[88:91] offset:17680
ds_write_b128 v120, v[92:95] offset:20000
ds_write_b128 v120, v[96:99] offset:22320
s_mov_b64 exec, 1
ds_add_u32 v116, v117 offset:0
s_mov_b64 exec, -1
s_mov_b32 s49, 0x80000
L_spin_1:
ds_read_b32 v123, v116 offset:0
s_waitcnt lgkmcnt(0)
v_readfirstlane_b32 s47, v123
s_cmp_ge_u32 s47, 4
s_cbranch_scc1 L_spun_2
s_sub_u32 s49, s49, 1
s_cbranch_scc0 L_spin_1
s_endpgm
L_spun_2:
ds_read_b128 v[4:7], v121 offset:15360
ds_read_b128 v[8:11], v121 offset:15488
ds_read_b128 v[12:15], v121 offset:24576
ds_read_b128 v[16:19], v121 offset:24704
s_waitcnt lgkmcnt(0)
v_pk_add_f32 v[4:5], v[4:5], v[12:13]
v_pk_add_f32 v[6:7], v[6:7], v[14:15]
v_pk_add_f32 v[8:9], v[8:9], v[16:17]
v_pk_add_f32 v[10:11], v[10:11], v[18:19]
v_pk_add_f32 v[4:5], v[4:5], v[8:9]
v_pk_add_f32 v[6:7], v[6:7], v[10:11]
v_cvt_pk_bf16_f32 v4, v4, v5
v_cvt_pk_bf16_f32 v5, v6, v7
v_min_u32 v4, -2, v4
v_min_u32 v5, -2, v5
buffer_store_dwordx2 v[4:5], v122, s[32:35], s46 offen
s_mov_b32 s49, 0x80000
L_spin_3:
ds_read_b32 v123, v116 offset:32
s_waitcnt lgkmcnt(0)
v_readfirstlane_b32 s47, v123
s_cmp_ge_u32 s47, 1
s_cbranch_scc1 L_spun_4
s_sleep 1
s_sub_u32 s49, s49, 1
s_cbranch_scc0 L_spin_3
s_endpgm
L_spun_4:
s_cmp_eq_u32 s47, 1
s_cbranch_scc1 L_qloc
buffer_store_dwordx2 v[4:5], v122, s[32:35], s46 offen sc1
L_qloc:
s_lshl_b32 s46, s7, 4
s_add_u32 s46, s46, s50
s_lshl_b32 s46, s46, 10
s_add_u32 s46, s46, s52
s_mov_b32 s49, 0x80000
L_spin_5:
ds_read_b32 v123, v116 offset:20
s_waitcnt lgkmcnt(0)
v_readfirstlane_b32 s47, v123
s_cmp_ge_u32 s47, 4
s_cbranch_scc1 L_spun_6
s_sleep 1
s_sub_u32 s49, s49, 1
s_cbranch_scc0 L_spin_5
s_endpgm
L_spun_6:
s_mov_b32 s49, 131072
s_branch L_qpoll
L_qretry:
s_sub_u32 s49, s49, 1
s_cbranch_scc1 L_end
s_sleep 2
L_qpoll:
buffer_load_dwordx2 v[20:21], v118, s[32:35], s46 offen offset:0 sc1
buffer_load_dwordx2 v[22:23], v118, s[32:35], s46 offen offset:256 sc1
buffer_load_dwordx2 v[24:25], v118, s[32:35], s46 offen offset:512 sc1
buffer_load_dwordx2 v[26:27], v118, s[32:35], s46 offen offset:768 sc1
s_waitcnt vmcnt(0)
v_max3_u32 v28, v20, v21, v22
v_max3_u32 v28, v28, v23, v24
v_max3_u32 v28, v28, v25, v26
v_max_u32 v28, v28, v27
v_cmp_eq_u32 vcc, -1, v28
s_cbranch_vccnz L_qretry
v_lshlrev_b32 v32, 16, v20
v_and_b32 v33, 0xffff0000, v20
v_lshlrev_b32 v34, 16, v21
v_and_b32 v35, 0xffff0000, v21
v_lshlrev_b32 v36, 16, v22
v_and_b32 v37, 0xffff0000, v22
v_lshlrev_b32 v38, 16, v23
v_and_b32 v39, 0xffff0000, v23
v_lshlrev_b32 v40, 16, v24
v_and_b32 v41, 0xffff0000, v24
v_lshlrev_b32 v42, 16, v25
v_and_b32 v43, 0xffff0000, v25
v_lshlrev_b32 v44, 16, v26
v_and_b32 v45, 0xffff0000, v26
v_lshlrev_b32 v46, 16, v27
v_and_b32 v47, 0xffff0000, v27
v_pk_add_f32 v[32:33], v[32:33], v[40:41]
v_pk_add_f32 v[34:35], v[34:35], v[42:43]
v_pk_add_f32 v[36:37], v[36:37], v[44:45]
v_pk_add_f32 v[38:39], v[38:39], v[46:47]
v_pk_add_f32 v[32:33], v[32:33], v[36:37]
v_pk_add_f32 v[34:35], v[34:35], v[38:39]
v_cvt_pk_bf16_f32 v20, v32, v33
v_cvt_pk_bf16_f32 v22, v34, v35
ds_write_b16 v2, v20 offset:64
ds_write_b16_d16_hi v2, v20 offset:80
ds_write_b16 v2, v22 offset:96
ds_write_b16_d16_hi v2, v22 offset:112
s_mov_b64 exec, 1
ds_add_u32 v116, v117 offset:4
s_mov_b64 exec, -1
s_mov_b32 s50, s7
L_G:
s_setprio 2
s_lshr_b32 s53, s4, 3
v_lshrrev_b32 v2, 5, v1
v_lshlrev_b32 v4, 6, v2
v_and_b32 v5, 3, v1
v_lshl_add_u32 v3, v5, 7, v4
s_lshl_b32 s46, s3, 2
s_add_u32 s46, s46, s53
s_lshl_b32 s46, s46, 3
s_add_u32 s46, s46, s50
s_lshl_b32 s52, s46, 9
s_add_u32 s52, s52, 131072
s_lshl_b32 s46, s46, 11
s_add_u32 s46, s46, 1048576
v_bfe_u32 v30, v1, 2, 1
v_lshlrev_b32 v30, 7, v30
v_lshl_add_u32 v30, v2, 6, v30
v_lshl_add_u32 v30, v5, 4, v30
v_bfe_u32 v4, v1, 3, 2
v_lshl_add_u32 v30, v4, 2, v30
s_mul_i32 s47, s50, 528
v_add_u32 v30, s47, v30
v_lshlrev_b32 v2, 3, v1
s_mov_b32 s49, 0x80000
L_spin_7:
ds_read_b32 v31, v116 offset:16
s_waitcnt lgkmcnt(0)
v_readfirstlane_b32 s47, v31
s_cmp_ge_u32 s47, 8
s_cbranch_scc1 L_spun_8
s_sleep 1
s_sub_u32 s49, s49, 1
s_cbranch_scc0 L_spin_7
s_endpgm
L_spun_8:
s_mov_b32 s49, 131072
s_branch L_opoll
L_oretry:
s_sub_u32 s49, s49, 1
s_cbranch_scc1 L_end
L_opoll:
buffer_load_dword v4, v3, s[32:35], s52 offen sc1
buffer_load_dwordx2 v[12:13], v2, s[32:35], s46 offen offset:0 sc1
buffer_load_dwordx2 v[14:15], v2, s[32:35], s46 offen offset:512 sc1
buffer_load_dwordx2 v[16:17], v2, s[32:35], s46 offen offset:1024 sc1
buffer_load_dwordx2 v[18:19], v2, s[32:35], s46 offen offset:1536 sc1
s_waitcnt vmcnt(4)
v_max_f32_dpp v6, v4, v4 quad_perm:[1,0,3,2] row_mask:0xf bank_mask:0xf
s_nop 1
v_max_f32_dpp v6, v6, v6 quad_perm:[2,3,0,1] row_mask:0xf bank_mask:0xf
v_sub_f32 v6, v4, v6
v_exp_f32 v6, v6
s_nop 1
v_add_f32_dpp v7, v6, v6 quad_perm:[1,0,3,2] row_mask:0xf bank_mask:0xf
s_nop 1
v_add_f32_dpp v7, v7, v7 quad_perm:[2,3,0,1] row_mask:0xf bank_mask:0xf
v_rcp_f32 v7, v7
s_waitcnt vmcnt(0)
v_mul_f32 v6, v6, v7
v_max3_u32 v28, v4, v12, v13
v_max3_u32 v28, v28, v14, v15
v_max3_u32 v28, v28, v16, v17
v_max3_u32 v28, v28, v18, v19
v_cmp_eq_u32 vcc, -1, v28
s_cbranch_vccnz L_oretry
v_lshlrev_b32 v32, 16, v12
v_and_b32 v33, 0xffff0000, v12
v_lshlrev_b32 v34, 16, v13
v_and_b32 v35, 0xffff0000, v13
v_lshlrev_b32 v36, 16, v14
v_and_b32 v37, 0xffff0000, v14
v_lshlrev_b32 v38, 16, v15
v_and_b32 v39, 0xffff0000, v15
v_lshlrev_b32 v40, 16, v16
v_and_b32 v41, 0xffff0000, v16
v_lshlrev_b32 v42, 16, v17
v_and_b32 v43, 0xffff0000, v17
v_lshlrev_b32 v44, 16, v18
v_and_b32 v45, 0xffff0000, v18
v_lshlrev_b32 v46, 16, v19
v_and_b32 v47, 0xffff0000, v19
v_mul_f32_dpp v32, v6, v32 quad_perm:[0,0,0,0] row_mask:0xf bank_mask:0xf
v_mul_f32_dpp v33, v6, v33 quad_perm:[0,0,0,0] row_mask:0xf bank_mask:0xf
v_mul_f32_dpp v34, v6, v34 quad_perm:[0,0,0,0] row_mask:0xf bank_mask:0xf
v_mul_f32_dpp v35, v6, v35 quad_perm:[0,0,0,0] row_mask:0xf bank_mask:0xf
v_fmac_f32_dpp v32, v6, v36 quad_perm:[1,1,1,1] row_mask:0xf bank_mask:0xf
v_fmac_f32_dpp v33, v6, v37 quad_perm:[1,1,1,1] row_mask:0xf bank_mask:0xf
v_fmac_f32_dpp v34, v6, v38 quad_perm:[1,1,1,1] row_mask:0xf bank_mask:0xf
v_fmac_f32_dpp v35, v6, v39 quad_perm:[1,1,1,1] row_mask:0xf bank_mask:0xf
v_fmac_f32_dpp v32, v6, v40 quad_perm:[2,2,2,2] row_mask:0xf bank_mask:0xf
v_fmac_f32_dpp v33, v6, v41 quad_perm:[2,2,2,2] row_mask:0xf bank_mask:0xf
v_fmac_f32_dpp v34, v6, v42 quad_perm:[2,2,2,2] row_mask:0xf bank_mask:0xf
v_fmac_f32_dpp v35, v6, v43 quad_perm:[2,2,2,2] row_mask:0xf bank_mask:0xf
v_fmac_f32_dpp v32, v6, v44 quad_perm:[3,3,3,3] row_mask:0xf bank_mask:0xf
v_fmac_f32_dpp v33, v6, v45 quad_perm:[3,3,3,3] row_mask:0xf bank_mask:0xf
v_fmac_f32_dpp v34, v6, v46 quad_perm:[3,3,3,3] row_mask:0xf bank_mask:0xf
v_fmac_f32_dpp v35, v6, v47 quad_perm:[3,3,3,3] row_mask:0xf bank_mask:0xf
v_cvt_pk_bf16_f32 v12, v32, v34
v_cvt_pk_bf16_f32 v13, v33, v35
ds_write_b32 v30, v12 offset:10752
ds_write_b32 v30, v13 offset:11008
s_waitcnt lgkmcnt(0)
s_barrier
s_endpgm
L_K:
s_setprio 2
v_bfe_u32 v2, v1, 1, 1
v_lshlrev_b32 v118, 15, v2
v_bfe_u32 v2, v1, 2, 2
v_lshl_add_u32 v118, v2, 8, v118
v_lshrrev_b32 v2, 4, v1
v_lshl_add_u32 v118, v2, 5, v118
v_and_b32 v2, 1, v1
v_lshl_add_u32 v118, v2, 4, v118
s_lshr_b32 s48, s4, 2
s_lshl_b32 s52, s48, 22
s_lshl_b32 s47, s6, 20
s_add_u32 s52, s52, s47
s_add_u32 s52, s52, 0xC0000
s_and_b32 s47, s4, 3
s_lshl_b32 s47, s47, 16
s_add_u32 s52, s52, s47
s_and_b32 s47, s7, 3
s_lshl_b32 s47, s47, 13
s_add_u32 s52, s52, s47
s_lshl_b32 s58, s48, 10
s_add_u32 s46, s52, s58
v_mov_b32 v116, 0
v_mov_b32 v117, 1
s_waitcnt lgkmcnt(0)
s_mov_b32 s28, s14
s_mov_b32 s29, s15
s_mov_b32 s30, 33554432
s_mov_b32 s31, 0x20000
s_mov_b32 s32, s24
s_mov_b32 s33, s25
s_mov_b32 s34, 16777216
s_mov_b32 s35, 0x20000
s_barrier
buffer_load_dwordx4 v[4:7], v118, s[28:31], s46 offen offset:0 nt
buffer_load_dwordx4 v[8:11], v118, s[28:31], s46 offen offset:128 nt
s_add_u32 s58, s58, 1024
s_and_b32 s58, s58, 8191
s_add_u32 s46, s52, s58
buffer_load_dwordx4 v[12:15], v118, s[28:31], s46 offen offset:0 nt
buffer_load_dwordx4 v[16:19], v118, s[28:31], s46 offen offset:128 nt
s_add_u32 s58, s58, 1024
s_and_b32 s58, s58, 8191
s_add_u32 s46, s52, s58
buffer_load_dwordx4 v[20:23], v118, s[28:31], s46 offen offset:0 nt
buffer_load_dwordx4 v[24:27], v118, s[28:31], s46 offen offset:128 nt
s_add_u32 s58, s58, 1024
s_and_b32 s58, s58, 8191
s_add_u32 s46, s52, s58
s_waitcnt vmcnt(5)
buffer_load_dwordx4 v[28:31], v118, s[28:31], s46 offen offset:0 nt
s_waitcnt vmcnt(5)
buffer_load_dwordx4 v[32:35], v118, s[28:31], s46 offen offset:128 nt
s_mov_b64 exec, 1
ds_add_u32 v116, v117 offset:36
s_mov_b64 exec, -1
s_add_u32 s58, s58, 1024
s_and_b32 s58, s58, 8191
s_add_u32 s46, s52, s58
s_waitcnt vmcnt(5)
buffer_load_dwordx4 v[36:39], v118, s[28:31], s46 offen offset:0 nt
s_waitcnt vmcnt(5)
buffer_load_dwordx4 v[40:43], v118, s[28:31], s46 offen offset:128 nt
s_add_u32 s58, s58, 1024
s_and_b32 s58, s58, 8191
s_add_u32 s46, s52, s58
s_waitcnt vmcnt(5)
buffer_load_dwordx4 v[44:47], v118, s[28:31], s46 offen offset:0 nt
s_waitcnt vmcnt(5)
buffer_load_dwordx4 v[48:51], v118, s[28:31], s46 offen offset:128 nt
s_add_u32 s58, s58, 1024
s_and_b32 s58, s58, 8191
s_add_u32 s46, s52, s58
s_waitcnt vmcnt(5)
buffer_load_dwordx4 v[52:55], v118, s[28:31], s46 offen offset:0 nt
s_waitcnt vmcnt(5)
buffer_load_dwordx4 v[56:59], v118, s[28:31], s46 offen offset:128 nt
s_add_u32 s58, s58, 1024
s_and_b32 s58, s58, 8191
s_add_u32 s46, s52, s58
s_waitcnt vmcnt(5)
buffer_load_dwordx4 v[60:63], v118, s[28:31], s46 offen offset:0 nt
s_waitcnt vmcnt(5)
buffer_load_dwordx4 v[64:67], v118, s[28:31], s46 offen offset:128 nt
s_mov_b64 exec, 1
ds_add_u32 v116, v117 offset:20
s_mov_b64 exec, -1
s_waitcnt vmcnt(5)
s_mov_b64 exec, 1
ds_add_u32 v116, v117 offset:24
s_mov_b64 exec, -1
v_and_b32 v2, 7, v1
v_mul_u32_u24 v118, 272, v2
v_lshrrev_b32 v2, 3, v1
v_lshl_add_u32 v118, v2, 4, v118
v_lshlrev_b32 v120, 4, v1
s_lshl_b32 s47, s7, 11
v_add_u32 v120, s47, v120
s_mov_b32 s51, 0x3e0293ee
s_waitcnt vmcnt(0)
s_mov_b32 s49, 0x80000
L_spin_9:
ds_read_b32 v2, v116 offset:4
s_waitcnt lgkmcnt(0)
v_readfirstlane_b32 s47, v2
s_cmp_ge_u32 s47, 4
s_cbranch_scc1 L_spun_10
s_sleep 1
s_sub_u32 s49, s49, 1
s_cbranch_scc0 L_spin_9
s_endpgm
L_spun_10:
ds_read_b128 v[68:71], v118 offset:64
ds_read_b128 v[72:75], v118 offset:192
s_waitcnt lgkmcnt(0)
v_mfma_f32_16x16x32_bf16 v[76:79], v[4:7], v[68:71], 0
v_mfma_f32_16x16x32_bf16 v[80:83], v[12:15], v[68:71], 0
v_mfma_f32_16x16x32_bf16 v[84:87], v[20:23], v[68:71], 0
v_mfma_f32_16x16x32_bf16 v[88:91], v[28:31], v[68:71], 0
v_mfma_f32_16x16x32_bf16 v[92:95], v[36:39], v[68:71], 0
v_mfma_f32_16x16x32_bf16 v[96:99], v[44:47], v[68:71], 0
v_mfma_f32_16x16x32_bf16 v[100:103], v[52:55], v[68:71], 0
v_mfma_f32_16x16x32_bf16 v[104:107], v[60:63], v[68:71], 0
v_mfma_f32_16x16x32_bf16 v[76:79], v[8:11], v[72:75], v[76:79]
v_mfma_f32_16x16x32_bf16 v[80:83], v[16:19], v[72:75], v[80:83]
v_mfma_f32_16x16x32_bf16 v[84:87], v[24:27], v[72:75], v[84:87]
v_mfma_f32_16x16x32_bf16 v[88:91], v[32:35], v[72:75], v[88:91]
v_mfma_f32_16x16x32_bf16 v[92:95], v[40:43], v[72:75], v[92:95]
v_mfma_f32_16x16x32_bf16 v[96:99], v[48:51], v[72:75], v[96:99]
v_mfma_f32_16x16x32_bf16 v[100:103], v[56:59], v[72:75], v[100:103]
v_mfma_f32_16x16x32_bf16 v[104:107], v[64:67], v[72:75], v[104:107]
s_nop 1
v_add_f32_dpp v4, v77, v76 row_ror:8 row_mask:0xf bank_mask:0xf
v_add_f32_dpp v5, v79, v78 row_ror:8 row_mask:0xf bank_mask:0xf
v_add_f32_dpp v6, v81, v80 row_ror:8 row_mask:0xf bank_mask:0xf
v_add_f32_dpp v7, v83, v82 row_ror:8 row_mask:0xf bank_mask:0xf
v_add_f32_dpp v8, v85, v84 row_ror:8 row_mask:0xf bank_mask:0xf
v_add_f32_dpp v9, v87, v86 row_ror:8 row_mask:0xf bank_mask:0xf
v_add_f32_dpp v10, v89, v88 row_ror:8 row_mask:0xf bank_mask:0xf
v_add_f32_dpp v11, v91, v90 row_ror:8 row_mask:0xf bank_mask:0xf
v_add_f32_dpp v12, v93, v92 row_ror:8 row_mask:0xf bank_mask:0xf
v_add_f32_dpp v13, v95, v94 row_ror:8 row_mask:0xf bank_mask:0xf
v_add_f32_dpp v14, v97, v96 row_ror:8 row_mask:0xf bank_mask:0xf
v_add_f32_dpp v15, v99, v98 row_ror:8 row_mask:0xf bank_mask:0xf
v_add_f32_dpp v16, v101, v100 row_ror:8 row_mask:0xf bank_mask:0xf
v_add_f32_dpp v17, v103, v102 row_ror:8 row_mask:0xf bank_mask:0xf
v_add_f32_dpp v18, v105, v104 row_ror:8 row_mask:0xf bank_mask:0xf
v_add_f32_dpp v19, v107, v106 row_ror:8 row_mask:0xf bank_mask:0xf
v_max3_f32 v20, v4, v5, v6
v_max3_f32 v20, v20, v7, v8
v_max3_f32 v20, v20, v9, v10
v_max3_f32 v20, v20, v11, v12
v_max3_f32 v20, v20, v13, v14
v_max3_f32 v20, v20, v15, v16
v_max3_f32 v20, v20, v17, v18
v_max_f32 v20, v20, v19
v_mov_b32 v21, v20
s_nop 1
v_permlane32_swap_b32 v20, v21
v_max_f32 v20, v20, v21
v_mov_b32 v21, v20
s_nop 1
v_permlane16_swap_b32 v20, v21
v_max_f32 v20, v20, v21
v_mul_f32 v20, s51, v20
v_fma_f32 v4, v4, s51, -v20
v_fma_f32 v5, v5, s51, -v20
v_fma_f32 v6, v6, s51, -v20
v_fma_f32 v7, v7, s51, -v20
v_fma_f32 v8, v8, s51, -v20
v_fma_f32 v9, v9, s51, -v20
v_fma_f32 v10, v10, s51, -v20
v_fma_f32 v11, v11, s51, -v20
v_fma_f32 v12, v12, s51, -v20
v_fma_f32 v13, v13, s51, -v20
v_fma_f32 v14, v14, s51, -v20
v_fma_f32 v15, v15, s51, -v20
v_fma_f32 v16, v16, s51, -v20
v_fma_f32 v17, v17, s51, -v20
v_fma_f32 v18, v18, s51, -v20
v_fma_f32 v19, v19, s51, -v20
v_exp_f32 v4, v4
v_exp_f32 v5, v5
v_exp_f32 v6, v6
v_exp_f32 v7, v7
v_exp_f32 v8, v8
v_exp_f32 v9, v9
v_exp_f32 v10, v10
v_exp_f32 v11, v11
v_exp_f32 v12, v12
v_exp_f32 v13, v13
v_exp_f32 v14, v14
v_exp_f32 v15, v15
v_exp_f32 v16, v16
v_exp_f32 v17, v17
v_exp_f32 v18, v18
v_exp_f32 v19, v19
s_nop 0
v_cvt_pk_bf16_f32 v24, v4, v5
v_cvt_pk_bf16_f32 v25, v6, v7
v_cvt_pk_bf16_f32 v26, v8, v9
v_cvt_pk_bf16_f32 v27, v10, v11
v_cvt_pk_bf16_f32 v28, v12, v13
v_cvt_pk_bf16_f32 v29, v14, v15
v_cvt_pk_bf16_f32 v30, v16, v17
v_cvt_pk_bf16_f32 v31, v18, v19
ds_write_b128 v120, v[24:27] offset:2304
ds_write_b128 v120, v[28:31] offset:3328
v_add_f32 v4, v4, v12
v_add_f32 v5, v5, v13
v_add_f32 v6, v6, v14
v_add_f32 v7, v7, v15
v_add_f32 v8, v8, v16
v_add_f32 v9, v9, v17
v_add_f32 v10, v10, v18
v_add_f32 v11, v11, v19
v_add_f32 v4, v4, v8
v_add_f32 v5, v5, v9
v_add_f32 v6, v6, v10
v_add_f32 v7, v7, v11
v_add_f32 v4, v4, v6
v_add_f32 v5, v5, v7
v_add_f32 v4, v4, v5
v_mov_b32 v21, v4
v_mov_b32 v22, v21
s_nop 1
v_permlane32_swap_b32 v21, v22
v_add_f32 v21, v21, v22
v_mov_b32 v22, v21
s_nop 1
v_permlane16_swap_b32 v21, v22
v_add_f32 v21, v21, v22
v_lshlrev_b32 v2, 3, v1
s_lshl_b32 s47, s7, 6
v_add_u32 v2, s47, v2
s_mov_b64 exec, 0xff
ds_write_b64 v2, v[20:21] offset:10496
s_mov_b64 exec, 1
ds_add_u32 v116, v117 offset:8
s_mov_b64 exec, -1
s_add_u32 s50, s7, 4
s_branch L_G
L_V:
s_setprio 2
v_lshlrev_b32 v118, 4, v1
v_lshrrev_b32 v2, 4, v1
v_and_b32 v109, 15, v1
v_lshlrev_b32 v109, 4, v109
v_lshl_add_u32 v109, v2, 8, v109
v_add_u32 v110, 32768, v109
s_lshr_b32 s48, s4, 2
s_lshl_b32 s52, s48, 22
s_lshl_b32 s47, s6, 20
s_add_u32 s52, s52, s47
s_add_u32 s52, s52, 0xC0000
s_and_b32 s47, s4, 3
s_lshl_b32 s47, s47, 16
s_add_u32 s52, s52, s47
s_and_b32 s47, s7, 3
s_lshl_b32 s47, s47, 13
s_add_u32 s52, s52, s47
s_lshl_b32 s58, s48, 10
s_add_u32 s46, s52, s58
v_mov_b32 v116, 0
v_mov_b32 v117, 1
v_mov_b32 v84, 0
v_mov_b32 v85, 0
v_mov_b32 v86, 0
v_mov_b32 v87, 0
v_mov_b32 v88, 0
v_mov_b32 v89, 0
v_mov_b32 v90, 0
v_mov_b32 v91, 0
v_mov_b32 v92, 0
v_mov_b32 v93, 0
v_mov_b32 v94, 0
v_mov_b32 v95, 0
v_mov_b32 v96, 0
v_mov_b32 v97, 0
v_mov_b32 v98, 0
v_mov_b32 v99, 0
v_and_b32 v120, 0x370, v118
s_lshl_b32 s47, s7, 11
v_add_u32 v120, s47, v120
v_lshrrev_b32 v2, 5, v1
v_lshlrev_b32 v3, 3, v2
s_lshl_b32 s47, s7, 4
v_add_u32 v3, s47, v3
v_lshlrev_b32 v2, 6, v2
v_and_b32 v126, 3, v1
v_lshl_add_u32 v108, v126, 4, v2
s_waitcnt lgkmcnt(0)
s_mov_b32 s28, s16
s_mov_b32 s29, s17
s_mov_b32 s30, 33554432
s_mov_b32 s31, 0x20000
s_mov_b32 s32, s24
s_mov_b32 s33, s25
s_mov_b32 s34, 16777216
s_mov_b32 s35, 0x20000
s_barrier
s_mov_b32 s49, 0x80000
L_spin_11:
ds_read_b32 v121, v116 offset:24
s_waitcnt lgkmcnt(0)
v_readfirstlane_b32 s47, v121
s_cmp_ge_u32 s47, 4
s_cbranch_scc1 L_spun_12
s_sleep 1
s_sub_u32 s49, s49, 1
s_cbranch_scc0 L_spin_11
s_endpgm
L_spun_12:
buffer_load_dwordx4 v[4:7], v109, s[28:31], s46 offen nt
buffer_load_dwordx4 v[8:11], v110, s[28:31], s46 offen nt
s_add_u32 s58, s58, 1024
s_and_b32 s58, s58, 8191
s_add_u32 s46, s52, s58
buffer_load_dwordx4 v[12:15], v109, s[28:31], s46 offen nt
buffer_load_dwordx4 v[16:19], v110, s[28:31], s46 offen nt
s_add_u32 s58, s58, 1024
s_and_b32 s58, s58, 8191
s_add_u32 s46, s52, s58
buffer_load_dwordx4 v[20:23], v109, s[28:31], s46 offen nt
buffer_load_dwordx4 v[24:27], v110, s[28:31], s46 offen nt
s_add_u32 s58, s58, 1024
s_and_b32 s58, s58, 8191
s_add_u32 s46, s52, s58
s_waitcnt vmcnt(5)
buffer_load_dwordx4 v[28:31], v109, s[28:31], s46 offen nt
s_waitcnt vmcnt(5)
buffer_load_dwordx4 v[32:35], v110, s[28:31], s46 offen nt
s_add_u32 s58, s58, 1024
s_and_b32 s58, s58, 8191
s_add_u32 s46, s52, s58
s_waitcnt vmcnt(5)
buffer_load_dwordx4 v[36:39], v109, s[28:31], s46 offen nt
s_waitcnt vmcnt(5)
buffer_load_dwordx4 v[40:43], v110, s[28:31], s46 offen nt
s_add_u32 s58, s58, 1024
s_and_b32 s58, s58, 8191
s_add_u32 s46, s52, s58
s_waitcnt vmcnt(5)
buffer_load_dwordx4 v[44:47], v109, s[28:31], s46 offen nt
s_waitcnt vmcnt(5)
buffer_load_dwordx4 v[48:51], v110, s[28:31], s46 offen nt
s_add_u32 s58, s58, 1024
s_and_b32 s58, s58, 8191
s_add_u32 s46, s52, s58
s_waitcnt vmcnt(5)
buffer_load_dwordx4 v[52:55], v109, s[28:31], s46 offen nt
s_waitcnt vmcnt(5)
buffer_load_dwordx4 v[56:59], v110, s[28:31], s46 offen nt
s_add_u32 s58, s58, 1024
s_and_b32 s58, s58, 8191
s_add_u32 s46, s52, s58
s_waitcnt vmcnt(5)
buffer_load_dwordx4 v[60:63], v109, s[28:31], s46 offen nt
s_waitcnt vmcnt(5)
buffer_load_dwordx4 v[64:67], v110, s[28:31], s46 offen nt
s_waitcnt vmcnt(5)
s_mov_b64 exec, 1
ds_add_u32 v116, v117 offset:28
s_mov_b64 exec, -1
v_lshlrev_b32 v118, 3, v1
s_lshl_b32 s52, s3, 2
s_add_u32 s52, s52, s7
s_lshl_b32 s52, s52, 5
s_add_u32 s52, s52, s4
s_lshl_b32 s46, s52, 7
s_add_u32 s46, s46, 131072
s_mov_b32 s49, 0x80000
L_spin_13:
ds_read_b32 v121, v116 offset:8
s_waitcnt lgkmcnt(0)
v_readfirstlane_b32 s47, v121
s_cmp_ge_u32 s47, 4
s_cbranch_scc1 L_spun_14
s_sub_u32 s49, s49, 1
s_cbranch_scc0 L_spin_13
s_endpgm
L_spun_14:
ds_read_b32 v121, v116 offset:32
ds_read_b64 v[100:101], v3 offset:10496
ds_read_b64 v[102:103], v3 offset:10560
ds_read_b64 v[104:105], v3 offset:10624
ds_read_b64 v[106:107], v3 offset:10688
s_mov_b64 exec, s[26:27]
ds_read_b128 v[84:87], v120 offset:2304
ds_read_b128 v[92:95], v120 offset:3328
s_not_b64 exec, exec
ds_read_b128 v[88:91], v120 offset:2304
ds_read_b128 v[96:99], v120 offset:3328
s_mov_b64 exec, -1
s_waitcnt lgkmcnt(0)
v_readfirstlane_b32 s59, v121
v_max3_f32 v126, v100, v102, v104
v_max_f32 v126, v126, v106
v_sub_f32 v122, v100, v126
v_sub_f32 v123, v102, v126
v_sub_f32 v124, v104, v126
v_sub_f32 v125, v106, v126
v_exp_f32 v122, v122
v_exp_f32 v123, v123
v_exp_f32 v124, v124
v_exp_f32 v125, v125
s_nop 0
v_mul_f32 v127, v122, v101
v_fmac_f32 v127, v123, v103
v_fmac_f32 v127, v124, v105
v_fmac_f32 v127, v125, v107
v_log_f32 v112, v127
v_rcp_f32 v127, v127
s_nop 0
v_add_f32 v112, v112, v126
v_mul_f32 v122, v122, v127
v_mul_f32 v123, v123, v127
v_mul_f32 v124, v124, v127
v_mul_f32 v125, v125, v127
v_min_u32 v112, -2, v112
v_mov_b32 v113, v112
v_mov_b32 v114, v112
v_mov_b32 v115, v112
s_mov_b32 exec_lo, 15
s_mov_b32 exec_hi, 15
s_cmp_eq_u32 s59, 2
s_cbranch_scc1 L_wt_15
buffer_store_dwordx4 v[112:115], v108, s[32:35], s46 offen
s_branch L_st_16
L_wt_15:
buffer_store_dwordx4 v[112:115], v108, s[32:35], s46 offen sc1
L_st_16:
s_mov_b64 exec, -1
v_lshrrev_b32 v2, 4, v1
v_mul_u32_u24 v2, 576, v2
v_bfe_u32 v3, v1, 3, 1
v_lshl_add_u32 v2, v3, 8, v2
v_and_b32 v3, 7, v1
v_lshl_add_u32 v2, v3, 4, v2
s_lshr_b32 s47, s7, 1
s_mul_i32 s47, s47, 8960
s_lshl_b32 s54, s7, 7
s_add_u32 s47, s47, s54
v_add_u32 v120, s47, v2
v_and_b32 v3, 3, v1
v_mul_u32_u24 v3, 2320, v3
v_bfe_u32 v2, v1, 3, 2
v_mul_u32_u24 v2, 576, v2
v_add_u32 v3, v3, v2
v_bfe_u32 v2, v1, 2, 1
v_lshl_add_u32 v3, v2, 8, v3
v_lshrrev_b32 v2, 5, v1
v_lshl_add_u32 v3, v2, 4, v3
s_lshl_b32 s47, s7, 5
v_add_u32 v3, s47, v3
s_lshl_b32 s46, s52, 9
s_add_u32 s46, s46, 1048576
v_perm_b32 v100, v8, v4, s44
v_perm_b32 v101, v16, v12, s44
v_perm_b32 v102, v24, v20, s44
v_perm_b32 v103, v32, v28, s44
v_perm_b32 v104, v8, v4, s45
v_perm_b32 v105, v16, v12, s45
v_perm_b32 v106, v24, v20, s45
v_perm_b32 v107, v32, v28, s45
v_mfma_f32_16x16x32_bf16 v[68:71], v[100:103], v[84:87], 0
v_perm_b32 v100, v9, v5, s44
v_perm_b32 v101, v17, v13, s44
v_perm_b32 v102, v25, v21, s44
v_perm_b32 v103, v33, v29, s44
v_mfma_f32_16x16x32_bf16 v[72:75], v[104:107], v[84:87], 0
v_perm_b32 v104, v9, v5, s45
v_perm_b32 v105, v17, v13, s45
v_perm_b32 v106, v25, v21, s45
v_perm_b32 v107, v33, v29, s45
v_mfma_f32_16x16x32_bf16 v[76:79], v[100:103], v[84:87], 0
v_perm_b32 v100, v10, v6, s44
v_perm_b32 v101, v18, v14, s44
v_perm_b32 v102, v26, v22, s44
v_perm_b32 v103, v34, v30, s44
v_mfma_f32_16x16x32_bf16 v[80:83], v[104:107], v[84:87], 0
v_perm_b32 v104, v10, v6, s45
v_perm_b32 v105, v18, v14, s45
v_perm_b32 v106, v26, v22, s45
v_perm_b32 v107, v34, v30, s45
v_mfma_f32_16x16x32_bf16 v[68:71], v[100:103], v[88:91], v[68:71]
v_perm_b32 v100, v11, v7, s44
v_perm_b32 v101, v19, v15, s44
v_perm_b32 v102, v27, v23, s44
v_perm_b32 v103, v35, v31, s44
v_mfma_f32_16x16x32_bf16 v[72:75], v[104:107], v[88:91], v[72:75]
v_perm_b32 v104, v11, v7, s45
v_perm_b32 v105, v19, v15, s45
v_perm_b32 v106, v27, v23, s45
v_perm_b32 v107, v35, v31, s45
v_mfma_f32_16x16x32_bf16 v[76:79], v[100:103], v[88:91], v[76:79]
s_nop 0
v_mfma_f32_16x16x32_bf16 v[80:83], v[104:107], v[88:91], v[80:83]
s_waitcnt vmcnt(7)
v_perm_b32 v4, v40, v36, s44
v_perm_b32 v8, v40, v36, s45
v_perm_b32 v12, v41, v37, s44
v_perm_b32 v16, v41, v37, s45
v_perm_b32 v20, v42, v38, s44
v_perm_b32 v24, v42, v38, s45
v_perm_b32 v28, v43, v39, s44
v_perm_b32 v32, v43, v39, s45
s_waitcnt vmcnt(5)
v_perm_b32 v5, v48, v44, s44
v_perm_b32 v9, v48, v44, s45
v_perm_b32 v13, v49, v45, s44
v_perm_b32 v17, v49, v45, s45
v_perm_b32 v21, v50, v46, s44
v_perm_b32 v25, v50, v46, s45
v_perm_b32 v29, v51, v47, s44
v_perm_b32 v33, v51, v47, s45
s_waitcnt vmcnt(3)
v_perm_b32 v6, v56, v52, s44
v_perm_b32 v10, v56, v52, s45
v_perm_b32 v14, v57, v53, s44
v_perm_b32 v18, v57, v53, s45
v_perm_b32 v22, v58, v54, s44
v_perm_b32 v26, v58, v54, s45
v_perm_b32 v30, v59, v55, s44
v_perm_b32 v34, v59, v55, s45
s_waitcnt vmcnt(1)
v_perm_b32 v7, v64, v60, s44
v_perm_b32 v11, v64, v60, s45
v_perm_b32 v15, v65, v61, s44
v_mfma_f32_16x16x32_bf16 v[68:71], v[4:7], v[92:95], v[68:71]
v_perm_b32 v19, v65, v61, s45
v_mfma_f32_16x16x32_bf16 v[72:75], v[8:11], v[92:95], v[72:75]
v_perm_b32 v23, v66, v62, s44
v_mfma_f32_16x16x32_bf16 v[76:79], v[12:15], v[92:95], v[76:79]
v_perm_b32 v27, v66, v62, s45
v_mfma_f32_16x16x32_bf16 v[80:83], v[16:19], v[92:95], v[80:83]
v_perm_b32 v31, v67, v63, s44
v_mfma_f32_16x16x32_bf16 v[68:71], v[20:23], v[96:99], v[68:71]
v_perm_b32 v35, v67, v63, s45
v_mfma_f32_16x16x32_bf16 v[72:75], v[24:27], v[96:99], v[72:75]
v_mfma_f32_16x16x32_bf16 v[76:79], v[28:31], v[96:99], v[76:79]
v_mfma_f32_16x16x32_bf16 v[80:83], v[32:35], v[96:99], v[80:83]
s_nop 3
ds_write_b128 v120, v[68:71] offset:15360
s_nop 0
ds_write_b128 v120, v[72:75] offset:17680
ds_write_b128 v120, v[76:79] offset:20000
ds_write_b128 v120, v[80:83] offset:22320
s_mov_b64 exec, 1
ds_add_u32 v116, v117 offset:12
s_mov_b64 exec, -1
s_mov_b32 s49, 0x80000
L_spin_17:
ds_read_b32 v121, v116 offset:12
s_waitcnt lgkmcnt(0)
v_readfirstlane_b32 s47, v121
s_cmp_ge_u32 s47, 4
s_cbranch_scc1 L_spun_18
s_sub_u32 s49, s49, 1
s_cbranch_scc0 L_spin_17
s_endpgm
L_spun_18:
ds_read_b128 v[4:7], v3 offset:15360
ds_read_b128 v[8:11], v3 offset:15488
ds_read_b128 v[12:15], v3 offset:24576
ds_read_b128 v[16:19], v3 offset:24704
s_waitcnt lgkmcnt(0)
v_mul_f32 v4, v122, v4
v_mul_f32 v5, v122, v5
v_mul_f32 v6, v122, v6
v_mul_f32 v7, v122, v7
v_fmac_f32 v4, v123, v8
v_fmac_f32 v5, v123, v9
v_fmac_f32 v6, v123, v10
v_fmac_f32 v7, v123, v11
v_fmac_f32 v4, v124, v12
v_fmac_f32 v5, v124, v13
v_fmac_f32 v6, v124, v14
v_fmac_f32 v7, v124, v15
v_fmac_f32 v4, v125, v16
v_fmac_f32 v5, v125, v17
v_fmac_f32 v6, v125, v18
v_fmac_f32 v7, v125, v19
v_cvt_pk_bf16_f32 v4, v4, v5
v_cvt_pk_bf16_f32 v5, v6, v7
v_min_u32 v4, -2, v4
v_min_u32 v5, -2, v5
s_cmp_eq_u32 s59, 2
s_cbranch_scc1 L_wt_19
buffer_store_dwordx2 v[4:5], v118, s[32:35], s46 offen
s_branch L_st_20
L_wt_19:
buffer_store_dwordx2 v[4:5], v118, s[32:35], s46 offen sc1
L_st_20:
s_mov_b64 exec, 1
ds_add_u32 v116, v117 offset:16
s_mov_b64 exec, -1
s_endpgm
L_WO:
s_setprio 1
v_mov_b32 v116, 0
v_lshlrev_b32 v2, 2, v1
s_mov_b64 exec, 0xffff
ds_write_b32 v2, v116
s_mov_b64 exec, -1
s_waitcnt lgkmcnt(0)
s_lshl_b32 s58, s5, 8
s_load_dword s40, s[24:25], s58
s_mov_b32 s32, s24
s_mov_b32 s33, s25
s_mov_b32 s34, 16777216
s_mov_b32 s35, 0x20000
s_cmp_lg_u32 s7, 3
s_cbranch_scc1 L_nohello
s_mov_b32 s59, 1
v_mov_b32 v4, -1
v_mov_b32 v5, -1
v_mov_b32 v6, -1
v_mov_b32 v7, -1
v_lshrrev_b32 v2, 4, v1
v_and_b32 v3, 15, v1
v_lshlrev_b32 v3, 4, v3
v_lshl_add_u32 v8, v2, 10, v3
v_lshrrev_b32 v2, 5, v1
v_and_b32 v3, 31, v1
v_lshlrev_b32 v3, 4, v3
v_lshl_add_u32 v9, v2, 14, v3
v_bfe_u32 v2, v1, 3, 2
v_and_b32 v11, 7, v1
v_lshlrev_b32 v11, 4, v11
v_lshl_add_u32 v10, v2, 12, v11
s_lshl_b32 s54, s3, 3
s_lshr_b32 s47, s4, 2
s_add_u32 s54, s54, s47
s_lshl_b32 s54, s54, 5
s_and_b32 s47, s4, 3
s_add_u32 s54, s54, s47
s_lshl_b32 s54, s54, 8
s_add_u32 s54, s54, 524288
s_add_u32 s55, s54, 4096
s_lshl_b32 s47, s3, 7
s_add_u32 s47, s47, s4
s_lshl_b32 s56, s47, 9
s_add_u32 s56, s56, 1048576
s_add_u32 s57, s56, 32768
s_lshl_b32 s48, s47, 7
s_add_u32 s48, s48, 131072
s_lshl_b32 s52, s3, 12
s_add_u32 s52, s52, 4096
buffer_store_dwordx4 v[4:7], v8, s[32:35], s54 offen
buffer_store_dwordx4 v[4:7], v8, s[32:35], s55 offen
buffer_store_dwordx4 v[4:7], v9, s[32:35], s56 offen
buffer_store_dwordx4 v[4:7], v9, s[32:35], s57 offen
s_mov_b32 exec_hi, 0
buffer_store_dwordx4 v[4:7], v10, s[32:35], s48 offen
s_mov_b32 exec_hi, -1
s_getreg_b32 s51, hwreg(HW_REG_XCC_ID, 0, 4)
s_waitcnt lgkmcnt(0)
s_add_u32 s9, s40, 0x9E3779B1
s_bfe_u32 s40, s9, 0xb0000
s_bfe_u32 s41, s9, 0xb0007
s_bfe_u32 s42, s9, 0xb000e
s_bfe_u32 s43, s9, 0xb0015
s_add_u32 s51, s51, s9
L_hello:
v_mov_b32 v12, s51
v_mov_b32 v13, s51
v_mov_b32 v14, s51
v_mov_b32 v15, s51
s_lshl_b32 s46, s4, 7
s_add_u32 s46, s46, s52
s_waitcnt vmcnt(0)
s_mov_b64 exec, 0xff
buffer_store_dwordx4 v[12:15], v11, s[32:35], s46 offen sc1
s_mov_b64 exec, -1
s_cmp_eq_u32 s59, 2
s_cbranch_scc1 L_hpoll0
s_barrier
s_mov_b32 s49, 0x80000
L_spin_21:
ds_read_b32 v16, v116 offset:36
s_waitcnt lgkmcnt(0)
v_readfirstlane_b32 s47, v16
s_cmp_ge_u32 s47, 4
s_cbranch_scc1 L_spun_22
s_sleep 1
s_sub_u32 s49, s49, 1
s_cbranch_scc0 L_spin_21
s_endpgm
L_spun_22:
L_hpoll0:
v_and_b32 v16, 31, v1
v_lshlrev_b32 v16, 7, v16
s_mov_b32 s49, 131072
L_hpoll:
buffer_load_dword v17, v16, s[32:35], s52 offen sc1
s_waitcnt vmcnt(0)
v_cmp_ne_u32 s[10:11], s51, v17
v_subrev_u32 v17, s9, v17
v_cmp_lt_u32 vcc, 15, v17
s_or_b32 s53, s10, s11
s_cbranch_vccz L_hall
s_sleep 8
s_sub_u32 s49, s49, 1
s_cbranch_scc0 L_hpoll
s_endpgm
L_hall:
s_cmp_eq_u32 s59, 2
s_cbranch_scc1 L_hdone
s_cmp_eq_u32 s53, 0
s_cbranch_scc1 L_hdone
s_mov_b32 s59, 2
s_add_u32 s52, s52, 0x8000
buffer_store_dwordx4 v[4:7], v8, s[32:35], s54 offen sc1
buffer_store_dwordx4 v[4:7], v8, s[32:35], s55 offen sc1
buffer_store_dwordx4 v[4:7], v9, s[32:35], s56 offen sc1
buffer_store_dwordx4 v[4:7], v9, s[32:35], s57 offen sc1
s_mov_b32 exec_hi, 0
buffer_store_dwordx4 v[4:7], v10, s[32:35], s48 offen sc1
s_mov_b32 exec_hi, -1
s_branch L_hello
L_hdone:
v_mov_b32 v4, s59
ds_write_b32 v116, v4 offset:32
s_branch L_wosetup
L_nohello:
s_getpc_b64 s[54:55]
L_pc:
s_sub_u32 s54, s54, L_pc-concat_heads__sliding_block_cached__sliding_block_cached__decode_kernel
s_subb_u32 s55, s55, 0
s_lshl_b32 s47, s7, 5
s_add_u32 s47, s47, s4
s_lshl_b32 s56, s47, 7
s_min_u32 s56, s56, L_end-concat_heads__sliding_block_cached__sliding_block_cached__decode_kernel
s_load_dword s57, s[54:55], s56
s_waitcnt lgkmcnt(0)
s_add_u32 s9, s40, 0x9E3779B1
s_bfe_u32 s40, s9, 0xb0000
s_bfe_u32 s41, s9, 0xb0007
s_bfe_u32 s42, s9, 0xb000e
s_bfe_u32 s43, s9, 0xb0015
s_barrier
L_wosetup:
v_lshrrev_b32 v2, 4, v1
v_and_b32 v3, 15, v1
v_lshlrev_b32 v3, 4, v3
v_lshl_add_u32 v118, v2, 11, v3
v_lshl_add_u32 v125, v2, 12, v3
s_lshr_b32 s47, s4, 3
s_lshl_b32 s50, s6, 2
s_add_u32 s50, s50, s47
s_and_b32 s51, s4, 7
s_lshl_b32 s46, s50, 19
s_lshl_b32 s47, s7, 13
s_add_u32 s46, s46, s47
s_lshl_b32 s47, s51, 8
s_add_u32 s46, s46, s47
v_and_b32 v3, 7, v1
v_mul_u32_u24 v123, 528, v3
v_lshl_add_u32 v123, v2, 4, v123
s_lshl_b32 s47, s7, 7
v_add_u32 v123, s47, v123
v_bfe_u32 v122, v1, 3, 1
v_lshlrev_b32 v122, 6, v122
v_lshl_add_u32 v122, v2, 4, v122
v_lshl_add_u32 v122, v3, 1, v122
v_lshrrev_b32 v2, 4, v1
v_mul_u32_u24 v2, 576, v2
v_bfe_u32 v3, v1, 3, 1
v_lshl_add_u32 v2, v3, 8, v2
v_and_b32 v3, 7, v1
v_lshl_add_u32 v2, v3, 4, v2
s_lshr_b32 s47, s7, 1
s_mul_i32 s47, s47, 8960
s_lshl_b32 s54, s7, 7
s_add_u32 s47, s47, s54
v_add_u32 v120, s47, v2
v_and_b32 v3, 3, v1
v_mul_u32_u24 v3, 2320, v3
v_bfe_u32 v2, v1, 3, 2
v_mul_u32_u24 v2, 576, v2
v_add_u32 v3, v3, v2
v_bfe_u32 v2, v1, 2, 1
v_lshl_add_u32 v3, v2, 8, v3
v_lshrrev_b32 v2, 5, v1
v_lshl_add_u32 v3, v2, 4, v3
s_lshl_b32 s47, s7, 5
v_add_u32 v3, s47, v3
v_mov_b32 v119, 0x7ff
v_mov_b32 v117, 1
v_lshlrev_b32 v2, 4, v1
v_mov_b32 v100, 0
v_mov_b32 v101, 0
v_mov_b32 v102, 0
v_mov_b32 v103, 0
v_mov_b32 v104, 0
v_mov_b32 v105, 0
v_mov_b32 v106, 0
v_mov_b32 v107, 0
v_mov_b32 v108, 0
v_mov_b32 v109, 0
v_mov_b32 v110, 0
v_mov_b32 v111, 0
v_mov_b32 v112, 0
v_mov_b32 v113, 0
v_mov_b32 v114, 0
v_mov_b32 v115, 0
s_mov_b32 s28, s20
s_mov_b32 s29, s21
s_mov_b32 s30, 8388608
s_mov_b32 s31, 0x20000
s_mov_b32 s36, s22
s_mov_b32 s37, s23
s_mov_b32 s38, 32768
s_mov_b32 s39, 0x20000
s_mov_b32 s49, 0x80000
L_spin_23:
ds_read_b32 v121, v116 offset:28
s_waitcnt lgkmcnt(0)
v_readfirstlane_b32 s47, v121
s_cmp_ge_u32 s47, 4
s_cbranch_scc1 L_spun_24
s_sleep 1
s_sub_u32 s49, s49, 1
s_cbranch_scc0 L_spin_23
s_endpgm
L_spun_24:
buffer_load_dwordx4 v[4:7], v118, s[28:31], s46 offen nt
s_add_u32 s46, s46, 32768
buffer_load_dwordx4 v[8:11], v118, s[28:31], s46 offen nt
s_add_u32 s46, s46, 32768
buffer_load_dwordx4 v[12:15], v118, s[28:31], s46 offen nt
s_add_u32 s46, s46, 32768
buffer_load_dwordx4 v[16:19], v118, s[28:31], s46 offen nt
s_add_u32 s46, s46, 32768
buffer_load_dwordx4 v[20:23], v118, s[28:31], s46 offen nt
s_add_u32 s46, s46, 32768
buffer_load_dwordx4 v[24:27], v118, s[28:31], s46 offen nt
s_add_u32 s46, s46, 32768
s_waitcnt vmcnt(5)
buffer_load_dwordx4 v[28:31], v118, s[28:31], s46 offen nt
s_add_u32 s46, s46, 32768
s_waitcnt vmcnt(5)
buffer_load_dwordx4 v[32:35], v118, s[28:31], s46 offen nt
s_mov_b64 exec, 1
ds_add_u32 v116, v117 offset:16
s_mov_b64 exec, -1
s_add_u32 s46, s46, 32768
s_waitcnt vmcnt(5)
buffer_load_dwordx4 v[36:39], v118, s[28:31], s46 offen nt
s_add_u32 s46, s46, 32768
s_waitcnt vmcnt(5)
buffer_load_dwordx4 v[40:43], v118, s[28:31], s46 offen nt
s_add_u32 s46, s46, 32768
s_waitcnt vmcnt(5)
buffer_load_dwordx4 v[44:47], v118, s[28:31], s46 offen nt
s_add_u32 s46, s46, 32768
s_waitcnt vmcnt(5)
buffer_load_dwordx4 v[48:51], v118, s[28:31], s46 offen nt
s_add_u32 s46, s46, 32768
s_waitcnt vmcnt(5)
buffer_load_dwordx4 v[52:55], v118, s[28:31], s46 offen nt
s_add_u32 s46, s46, 32768
s_waitcnt vmcnt(5)
buffer_load_dwordx4 v[56:59], v118, s[28:31], s46 offen nt
s_add_u32 s46, s46, 32768
s_waitcnt vmcnt(5)
buffer_load_dwordx4 v[60:63], v118, s[28:31], s46 offen nt
s_add_u32 s46, s46, 32768
s_waitcnt vmcnt(5)
buffer_load_dwordx4 v[64:67], v118, s[28:31], s46 offen nt
s_lshl_b32 s46, s5, 3
s_add_u32 s46, s46, s51
s_lshl_b32 s46, s46, 16
s_add_u32 s46, s46, 2097152
s_lshl_b32 s47, s50, 12
s_add_u32 s48, s46, s47
s_lshl_b32 s47, s7, 14
s_add_u32 s46, s46, s47
s_lshl_b32 s47, s50, 8
s_add_u32 s46, s46, s47
s_lshr_b32 s52, s50, 1
s_lshl_b32 s52, s52, 12
s_lshl_b32 s47, s5, 11
s_add_u32 s52, s52, s47
s_lshl_b32 s47, s51, 8
s_add_u32 s52, s52, s47
s_and_b32 s47, s50, 1
s_lshl_b32 s47, s47, 7
s_add_u32 s52, s52, s47
s_mov_b32 s49, 131072
s_waitcnt vmcnt(14)
v_perm_b32 v68, v8, v4, s44
v_perm_b32 v72, v8, v4, s45
v_perm_b32 v76, v9, v5, s44
v_perm_b32 v80, v9, v5, s45
v_perm_b32 v84, v10, v6, s44
v_perm_b32 v88, v10, v6, s45
v_perm_b32 v92, v11, v7, s44
v_perm_b32 v96, v11, v7, s45
s_waitcnt vmcnt(12)
v_perm_b32 v69, v16, v12, s44
v_perm_b32 v73, v16, v12, s45
v_perm_b32 v77, v17, v13, s44
v_perm_b32 v81, v17, v13, s45
v_perm_b32 v85, v18, v14, s44
v_perm_b32 v89, v18, v14, s45
v_perm_b32 v93, v19, v15, s44
v_perm_b32 v97, v19, v15, s45
s_waitcnt vmcnt(10)
v_perm_b32 v70, v24, v20, s44
v_perm_b32 v74, v24, v20, s45
v_perm_b32 v78, v25, v21, s44
v_perm_b32 v82, v25, v21, s45
v_perm_b32 v86, v26, v22, s44
v_perm_b32 v90, v26, v22, s45
v_perm_b32 v94, v27, v23, s44
v_perm_b32 v98, v27, v23, s45
s_waitcnt vmcnt(8)
v_perm_b32 v71, v32, v28, s44
v_perm_b32 v75, v32, v28, s45
v_perm_b32 v79, v33, v29, s44
v_perm_b32 v83, v33, v29, s45
v_perm_b32 v87, v34, v30, s44
v_perm_b32 v91, v34, v30, s45
v_perm_b32 v95, v35, v31, s44
v_perm_b32 v99, v35, v31, s45
s_waitcnt vmcnt(6)
v_perm_b32 v4, v40, v36, s44
v_perm_b32 v8, v40, v36, s45
v_perm_b32 v12, v41, v37, s44
v_perm_b32 v16, v41, v37, s45
v_perm_b32 v20, v42, v38, s44
v_perm_b32 v24, v42, v38, s45
v_perm_b32 v28, v43, v39, s44
v_perm_b32 v32, v43, v39, s45
s_waitcnt vmcnt(4)
v_perm_b32 v5, v48, v44, s44
v_perm_b32 v9, v48, v44, s45
v_perm_b32 v13, v49, v45, s44
v_perm_b32 v17, v49, v45, s45
v_perm_b32 v21, v50, v46, s44
v_perm_b32 v25, v50, v46, s45
v_perm_b32 v29, v51, v47, s44
v_perm_b32 v33, v51, v47, s45
s_waitcnt vmcnt(2)
v_perm_b32 v6, v56, v52, s44
v_perm_b32 v10, v56, v52, s45
v_perm_b32 v14, v57, v53, s44
v_perm_b32 v18, v57, v53, s45
v_perm_b32 v22, v58, v54, s44
v_perm_b32 v26, v58, v54, s45
v_perm_b32 v30, v59, v55, s44
v_perm_b32 v34, v59, v55, s45
s_setprio 3
s_barrier
s_mov_b64 exec, s[26:27]
ds_read_b128 v[100:103], v123 offset:10752
ds_read_b128 v[108:111], v123 offset:10816
s_not_b64 exec, exec
ds_read_b128 v[104:107], v123 offset:10752
ds_read_b128 v[112:115], v123 offset:10816
s_mov_b64 exec, -1
s_waitcnt lgkmcnt(0)
v_mfma_f32_16x16x32_bf16 v[36:39], v[68:71], v[100:103], 0
v_mfma_f32_16x16x32_bf16 v[40:43], v[72:75], v[100:103], 0
v_mfma_f32_16x16x32_bf16 v[44:47], v[76:79], v[100:103], 0
v_mfma_f32_16x16x32_bf16 v[48:51], v[80:83], v[100:103], 0
v_mfma_f32_16x16x32_bf16 v[36:39], v[84:87], v[104:107], v[36:39]
v_mfma_f32_16x16x32_bf16 v[40:43], v[88:91], v[104:107], v[40:43]
v_mfma_f32_16x16x32_bf16 v[44:47], v[92:95], v[104:107], v[44:47]
v_mfma_f32_16x16x32_bf16 v[48:51], v[96:99], v[104:107], v[48:51]
s_waitcnt vmcnt(0)
s_memtime s[78:79]
v_perm_b32 v7, v64, v60, s44
v_perm_b32 v11, v64, v60, s45
v_perm_b32 v15, v65, v61, s44
v_mfma_f32_16x16x32_bf16 v[36:39], v[4:7], v[108:111], v[36:39]
v_perm_b32 v19, v65, v61, s45
v_mfma_f32_16x16x32_bf16 v[40:43], v[8:11], v[108:111], v[40:43]
v_perm_b32 v23, v66, v62, s44
v_mfma_f32_16x16x32_bf16 v[44:47], v[12:15], v[108:111], v[44:47]
v_perm_b32 v27, v66, v62, s45
v_mfma_f32_16x16x32_bf16 v[48:51], v[16:19], v[108:111], v[48:51]
v_perm_b32 v31, v67, v63, s44
v_mfma_f32_16x16x32_bf16 v[36:39], v[20:23], v[112:115], v[36:39]
v_perm_b32 v35, v67, v63, s45
v_mfma_f32_16x16x32_bf16 v[40:43], v[24:27], v[112:115], v[40:43]
v_mfma_f32_16x16x32_bf16 v[44:47], v[28:31], v[112:115], v[44:47]
v_mfma_f32_16x16x32_bf16 v[48:51], v[32:35], v[112:115], v[48:51]
s_nop 3
ds_write_b128 v120, v[36:39] offset:15360
s_nop 0
ds_write_b128 v120, v[40:43] offset:17680
ds_write_b128 v120, v[44:47] offset:20000
ds_write_b128 v120, v[48:51] offset:22320
s_waitcnt lgkmcnt(0)
s_barrier
ds_read_b128 v[68:71], v3 offset:15360
ds_read_b128 v[72:75], v3 offset:15488
ds_read_b128 v[76:79], v3 offset:24576
ds_read_b128 v[80:83], v3 offset:24704
s_waitcnt lgkmcnt(0)
v_pk_add_f32 v[68:69], v[68:69], v[76:77]
v_pk_add_f32 v[70:71], v[70:71], v[78:79]
v_pk_add_f32 v[72:73], v[72:73], v[80:81]
v_pk_add_f32 v[74:75], v[74:75], v[82:83]
v_pk_add_f32 v[68:69], v[68:69], v[72:73]
v_pk_add_f32 v[70:71], v[70:71], v[74:75]
v_bfi_b32 v68, v119, s40, v68
v_bfi_b32 v69, v119, s41, v69
v_bfi_b32 v70, v119, s42, v70
v_bfi_b32 v71, v119, s43, v71
buffer_store_dwordx4 v[68:71], v125, s[32:35], s46 offen sc1
s_cmp_lg_u32 s7, 0
s_cbranch_scc1 L_fin
s_waitcnt vmcnt(0)
s_branch L_rpoll
L_rretry:
s_sub_u32 s49, s49, 1
s_cbranch_scc1 L_end
L_rpoll:
buffer_load_dwordx4 v[12:15], v2, s[32:35], s48 offen offset:0 sc1
buffer_load_dwordx4 v[16:19], v2, s[32:35], s48 offen offset:1024 sc1
buffer_load_dwordx4 v[20:23], v2, s[32:35], s48 offen offset:2048 sc1
buffer_load_dwordx4 v[24:27], v2, s[32:35], s48 offen offset:3072 sc1
s_waitcnt vmcnt(0)
v_xor_b32 v12, s40, v12
v_xor_b32 v13, s41, v13
v_xor_b32 v14, s42, v14
v_xor_b32 v15, s43, v15
v_xor_b32 v16, s40, v16
v_xor_b32 v17, s41, v17
v_xor_b32 v18, s42, v18
v_xor_b32 v19, s43, v19
v_xor_b32 v20, s40, v20
v_xor_b32 v21, s41, v21
v_xor_b32 v22, s42, v22
v_xor_b32 v23, s43, v23
v_xor_b32 v24, s40, v24
v_xor_b32 v25, s41, v25
v_xor_b32 v26, s42, v26
v_xor_b32 v27, s43, v27
v_or3_b32 v28, v12, v13, v14
v_or3_b32 v29, v15, v16, v17
v_or3_b32 v30, v18, v19, v20
v_or3_b32 v31, v21, v22, v23
v_or3_b32 v32, v24, v25, v26
v_or3_b32 v28, v28, v29, v30
v_or3_b32 v31, v31, v32, v27
v_bitop3_b32 v28, v28, v31, v119 bitop3:0xa8
v_cmp_ne_u32 vcc, 0, v28
s_cbranch_vccnz L_rretry
v_pk_add_f32 v[12:13], v[12:13], v[20:21]
v_pk_add_f32 v[14:15], v[14:15], v[22:23]
v_pk_add_f32 v[16:17], v[16:17], v[24:25]
v_pk_add_f32 v[18:19], v[18:19], v[26:27]
v_pk_add_f32 v[12:13], v[12:13], v[16:17]
v_pk_add_f32 v[14:15], v[14:15], v[18:19]
s_nop 1
v_permlane32_swap_b32 v12, v14
v_permlane32_swap_b32 v13, v15
v_add_f32 v12, v12, v14
v_add_f32 v13, v13, v15
s_nop 1
v_permlane16_swap_b32 v12, v13
v_add_f32 v12, v12, v13
v_cvt_pk_bf16_f32 v12, v12, v12
buffer_store_short v12, v122, s[36:39], s52 offen
s_or_b32 s47, s6, s4
s_cmp_lg_u32 s47, 0
s_cbranch_scc1 L_fin
v_mov_b32 v4, s9
v_mov_b32 v5, 0
s_mov_b64 exec, 1
buffer_store_dword v4, v5, s[32:35], s58 offen
L_fin:
L_end:
s_endpgm
.section .rodata,"a"
.p2align 6
.amdhsa_kernel concat_heads__sliding_block_cached__sliding_block_cached__decode_kernel
  .amdhsa_next_free_vgpr 128
  .amdhsa_next_free_sgpr 96
  .amdhsa_accum_offset 128
  .amdhsa_group_segment_fixed_size 0
  .amdhsa_kernarg_size 104
  .amdhsa_user_sgpr_count 2
  .amdhsa_user_sgpr_kernarg_segment_ptr 1
  .amdhsa_system_sgpr_workgroup_id_x 1
.end_amdhsa_kernel
```
